```python
import torch

def _softmax(x, axis=-1):
    return torch.softmax(x, dim=axis)
def _gelu(x):
    return torch.nn.functional.gelu(x, approximate="tanh")
def _silu(x):
    return torch.nn.functional.silu(x)
def _sigmoid(x):
    return torch.sigmoid(x)
def _layernorm(x, axis=-1, eps=1e-5):
    m = x.mean(dim=axis, keepdim=True)
    v = x.var(dim=axis, keepdim=True, unbiased=False)
    return (x - m) / torch.sqrt(v + eps)
def _scatter_add(tgt, idx, src, axis=0):
    return tgt.clone().index_add_(axis, idx, src)
def _segment_sum(src, seg, n):
    out = torch.zeros((n,) + src.shape[1:], dtype=src.dtype)
    return out.index_add_(0, seg, src)
def _pad(x, pw):
    flat = tuple(v for pair in reversed(pw) for v in pair)
    return torch.nn.functional.pad(x, flat)

kernel_name = 'recurrent_scan__sliding_block_cached__geglu_ffn__decode'

def setup_inputs():

    _w = (lambda a: (lambda t: t.to(torch.bfloat16) if t.is_floating_point() else t)(torch.as_tensor(a)))
    def _A_setup():
        B, Sq, D = 8, 1, 512
        Hq, Hkv, Sk, Dh = 32, 8, 4096, 128
        assert Hq % Hkv == 0, (Hq, Hkv)
        return {
            "x": _w((lambda *s: torch.randn(*s, dtype=torch.bfloat16) * 0.05)(B, Sq, D)),
            "k_cache": _w((lambda *s: torch.randn(*s, dtype=torch.bfloat16) * 0.8)(B, Hkv, Sk, Dh)),
            "v_cache": _w((lambda *s: torch.randn(*s, dtype=torch.bfloat16) * 0.2)(B, Hkv, Sk, Dh)),
            "wq": _w((lambda *s: torch.randn(*s, dtype=torch.bfloat16) * 0.8)(D, Hq * Dh) * (D ** -0.5)),
            "wo": _w((lambda *s: torch.randn(*s, dtype=torch.bfloat16) * 0.2)(Hq * Dh, D) * ((Hq * Dh) ** -0.5)),
        }
    _A_in = _A_setup()

    def _B_setup():
        B, S, D, F = 8, 1, 512, 1792
        return {
            "x": _w((lambda *s: torch.randn(*s, dtype=torch.bfloat16) * 0.05)(B, S, D)),
            "w_gate": _w((lambda *s: torch.randn(*s, dtype=torch.bfloat16) * 0.1)(D, F)),
            "w_up": _w((lambda *s: torch.randn(*s, dtype=torch.bfloat16) * 0.1)(D, F)),
            "w_down": _w((lambda *s: torch.randn(*s, dtype=torch.bfloat16) * 0.1)(F, D)),
        }
    _B_in = _B_setup()

    return {
        "A_x": _A_in["x"],
        "A_k_cache": _A_in["k_cache"],
        "A_v_cache": _A_in["v_cache"],
        "A_wq": _A_in["wq"],
        "A_wo": _A_in["wo"],
        "B_x": _B_in["x"],
        "B_w_gate": _B_in["w_gate"],
        "B_w_up": _B_in["w_up"],
        "B_w_down": _B_in["w_down"],
    }

def reference(A_x, A_k_cache, A_v_cache, A_wq, A_wo, B_x, B_w_gate, B_w_up, B_w_down):
    def _A_ref(x, k_cache, v_cache, wq, wo):
        B, Sq, D = x.shape
        Hq, Dh = 32, 128
        Hkv, Sk = k_cache.shape[1], k_cache.shape[2]
        W = min(4096, max(256, Sk // 4))
        rep = Hq // Hkv
        q = (lambda x, *d: x.permute(*d))((x @ wq).reshape(B, Sq, Hq, Dh), 0, 2, 1, 3)
        k = (lambda x, n, axis: torch.repeat_interleave(x, n, dim=axis))(k_cache[:, :, Sk - W:, :], rep, axis=1)
        v = (lambda x, n, axis: torch.repeat_interleave(x, n, dim=axis))(v_cache[:, :, Sk - W:, :], rep, axis=1)
        scores = torch.einsum("bhqd,bhkd->bhqk", q, k) * (Dh ** -0.5)
        p = _softmax(scores, axis=-1)
        o = torch.einsum("bhqk,bhkd->bhqd", p, v)
        return (lambda x, *d: x.permute(*d))(o, 0, 2, 1, 3).reshape(B, Sq, Hq * Dh) @ wo

    def _B_ref(x, w_gate, w_up, w_down):
        return (_gelu(x @ w_gate) * (x @ w_up)) @ w_down

    x = A_x
    xn = _layernorm(x, axis=-1)
    s = _A_ref(xn, A_k_cache, A_v_cache, A_wq, A_wo)
    g = _silu(_B_ref(xn, B_w_gate, B_w_up, B_w_down))
    return x + s * g
```

```asm
; @launch grid=(256,1,1) block=(512,1,1) lds=51456
.amdgcn_target "amdgcn-amd-amdhsa--gfx950"
.text
.globl recurrent_scan__sliding_block_cached__geglu_ffn__decode_kernel
.p2align 8
.type recurrent_scan__sliding_block_cached__geglu_ffn__decode_kernel,@function
recurrent_scan__sliding_block_cached__geglu_ffn__decode_kernel:
    s_cmp_ge_u32 s2, 256
    s_cbranch_scc1 L_end
    s_load_dwordx2 s[4:5], s[0:1], 0
    s_load_dwordx2 s[40:41], s[0:1], 24
    s_load_dwordx4 s[44:47], s[0:1], 48
    s_load_dwordx2 s[8:9], s[0:1], 8
    s_load_dwordx2 s[12:13], s[0:1], 16
    s_load_dwordx2 s[32:33], s[0:1], 80
    s_load_dwordx2 s[36:37], s[0:1], 88
    s_getpc_b64 s[60:61]
L_pc:
    v_lshrrev_b32 v3, 6, v0
    v_lshlrev_b32 v4, 7, v0
    v_cmp_gt_u32 vcc, (L_codeend-L_pc+127)/128, v0
    v_readfirstlane_b32 s3, v3
    s_and_saveexec_b64 s[64:65], vcc
    s_cbranch_execz L_nopf
    global_load_dword v189, v4, s[60:61]
L_nopf:
    s_mov_b64 exec, s[64:65]
    s_and_b32 s42, s2, 7
    s_lshr_b32 s43, s2, 3
    s_cmp_ge_u32 s3, 4
    s_cbranch_scc1 L_Apro
L_G:
    s_memrealtime s[74:75]
    v_mov_b32 v191, 0
    v_lshrrev_b32 v3, 5, v0
    v_and_b32 v5, 31, v0
    v_lshlrev_b32 v4, 10, v3
    v_lshl_add_u32 v4, v5, 4, v4
    v_mul_u32_u24 v6, 1056, v3
    v_lshl_add_u32 v6, v5, 4, v6
    v_and_b32 v0, 63, v0
    s_movk_i32 s51, 3584
    s_sub_u32 s66, s43, 16
    s_lshr_b32 s66, s66, 2
    s_lshl_b32 s66, s66, 3
    s_add_u32 s66, s66, s42
    s_cmp_lt_u32 s66, 28
    s_cselect_b32 s18, 0x1c0000, 0
    s_lshr_b32 s67, s43, 1
    s_lshl_b32 s68, s42, 3
    s_add_u32 s67, s67, s68
    s_cmp_lt_u32 s43, 16
    s_cselect_b32 s51, 8192, s51
    s_cselect_b32 s18, 0x400000, s18
    s_cselect_b32 s66, s67, s66
    s_lshl_b32 s66, s66, 7
    s_and_b32 s67, s43, 1
    s_lshl_b32 s67, s67, 2
    s_add_u32 s67, s67, s3
    s_lshl_b32 s67, s67, 6
    s_mul_i32 s50, s67, s51
    s_add_u32 s50, s50, s66
    v_and_b32 v168, 0x38, v0
    v_mul_u32_u24 v182, s51, v168
    v_and_b32 v5, 7, v0
    v_lshl_add_u32 v182, v5, 4, v182
    s_mov_b32 s6, 8192
    s_mov_b32 s7, 0x00020000
    s_mov_b32 s19, 0x00020000
    s_mov_b32 s34, 256
    s_mov_b32 s35, 0x00020000
    s_or_b32 s66, s2, s3
    s_cmp_lg_u32 s66, 0
    s_waitcnt lgkmcnt(0)
    s_cbranch_scc1 L_nononce
    s_or_b32 s66, s74, 1
    v_mov_b32 v3, s66
    v_lshlrev_b32 v7, 6, v0
    s_mov_b64 exec, 15
    buffer_store_dword v3, v7, s[32:35], 0 offen sc0 sc1
    s_mov_b64 exec, -1
L_nononce:
    buffer_load_dwordx4 v[16:19], v4, s[4:7], 0 offen
    buffer_load_dwordx4 v[20:23], v4, s[4:7], 0 offen offset:512
    s_bitcmp1_b32 s43, 1
    s_cselect_b64 s[16:17], s[46:47], s[44:45]
    s_cmp_lt_u32 s43, 16
    s_cselect_b64 s[16:17], s[40:41], s[16:17]
    buffer_load_dwordx4 v[48:51], v182, s[16:19], s50 offen nt
    s_add_u32 s50, s50, s51
    buffer_load_dwordx4 v[52:55], v182, s[16:19], s50 offen nt
    s_add_u32 s50, s50, s51
    buffer_load_dwordx4 v[56:59], v182, s[16:19], s50 offen nt
    s_add_u32 s50, s50, s51
    buffer_load_dwordx4 v[60:63], v182, s[16:19], s50 offen nt
    s_add_u32 s50, s50, s51
    buffer_load_dwordx4 v[64:67], v182, s[16:19], s50 offen nt
    s_add_u32 s50, s50, s51
    buffer_load_dwordx4 v[68:71], v182, s[16:19], s50 offen nt
    s_add_u32 s50, s50, s51
    buffer_load_dwordx4 v[72:75], v182, s[16:19], s50 offen nt
    s_add_u32 s50, s50, s51
    buffer_load_dwordx4 v[76:79], v182, s[16:19], s50 offen nt
    s_cmp_lg_u32 s3, 0
    s_cbranch_scc1 L_noinit
    v_mov_b32 v8, 0
    v_mov_b32 v9, 0
    v_mov_b32 v10, 0
    v_mov_b32 v11, 0
    s_mov_b64 exec, 1
    ds_write_b128 v191, v[8:11] offset:9728
    ds_write_b128 v191, v[8:11] offset:9744
    ds_write_b128 v191, v[8:11] offset:9760
    s_mov_b64 exec, -1
    s_waitcnt lgkmcnt(0)
L_noinit:
    s_barrier
    s_branch L_G2
L_Apro:
    s_sub_u32 s3, s3, 4
    v_and_b32 v0, 63, v0
    v_bfe_u32 v1, v0, 2, 2
    v_lshrrev_b32 v3, 4, v0
    v_lshlrev_b32 v1, 8, v1
    v_and_b32 v4, 3, v0
    v_lshl_add_u32 v1, v3, 6, v1
    v_lshl_add_u32 v1, v4, 4, v1
    s_lshr_b32 s66, s43, 2
    s_lshl_b32 s66, s66, 3
    s_add_u32 s66, s66, s42
    s_lshl_b32 s48, s66, 20
    s_and_b32 s66, s43, 3
    s_lshl_b32 s66, s66, 16
    s_add_u32 s48, s48, s66
    s_lshl_b32 s66, s3, 10
    s_add_u32 s48, s48, s66
    s_add_u32 s48, s48, 0xc0000
    s_mov_b32 s10, 0x4000000
    s_mov_b32 s11, 0x00020000
    s_mov_b32 s49, s48
    s_waitcnt lgkmcnt(0)
    buffer_load_dwordx4 a[0:3], v1, s[8:11], s48 offen nt
    s_add_u32 s48, s48, 4096
    buffer_load_dwordx4 a[4:7], v1, s[8:11], s48 offen nt
    s_add_u32 s48, s48, 4096
    buffer_load_dwordx4 a[8:11], v1, s[8:11], s48 offen nt
    s_add_u32 s48, s48, 4096
    buffer_load_dwordx4 a[12:15], v1, s[8:11], s48 offen nt
    s_add_u32 s48, s48, 4096
    buffer_load_dwordx4 a[16:19], v1, s[8:11], s48 offen nt
    s_add_u32 s48, s48, 4096
    buffer_load_dwordx4 a[20:23], v1, s[8:11], s48 offen nt
    s_add_u32 s48, s48, 4096
    buffer_load_dwordx4 a[24:27], v1, s[8:11], s48 offen nt
    s_add_u32 s48, s48, 4096
    buffer_load_dwordx4 a[28:31], v1, s[8:11], s48 offen nt
    s_add_u32 s48, s48, 4096
    s_barrier
    s_branch L_A
L_G2:
    s_load_dwordx2 s[24:25], s[0:1], 64
    s_load_dwordx2 s[28:29], s[0:1], 72
    v_mov_b32 v1, 1
    s_mov_b32 s26, 0x1c0000
    s_mov_b32 s27, 0x00020000
    s_mov_b32 s30, 0x2000
    s_mov_b32 s31, 0x00020000
    s_mov_b32 s38, 0x400000
    s_mov_b32 s39, 0x00020000
    s_mov_b32 s56, 0x05040100
    s_mov_b32 s57, 0x07060302
    s_mov_b32 s76, 0xffff0000
    v_mul_u32_u24 v3, 1056, v5
    v_lshl_add_u32 v168, v168, 1, v3
    s_lshl_b32 s67, s67, 1
    v_add_u32 v168, s67, v168
    v_bfe_u32 v184, v0, 4, 1
    v_lshlrev_b32 v184, 13, v184
    v_and_b32 v3, 15, v0
    v_lshl_add_u32 v184, v3, 4, v184
    s_lshl_b32 s66, s3, 8
    s_add_u32 s66, s66, 18688
    v_add_u32 v184, s66, v184
    v_lshrrev_b32 v185, 5, v0
    v_lshlrev_b32 v185, 13, v185
    v_lshl_add_u32 v185, v5, 4, v185
    v_bfe_u32 v3, v0, 3, 2
    v_lshl_add_u32 v185, v3, 2, v185
    s_lshl_b32 s66, s3, 11
    s_add_u32 s66, s66, 18688
    v_add_u32 v185, s66, v185
    v_lshrrev_b32 v183, 3, v0
    v_lshlrev_b32 v183, 9, v183
    v_lshl_add_u32 v183, v5, 4, v183
    s_lshl_b32 s66, s3, 7
    v_add_u32 v183, s66, v183
    s_lshl_b32 s58, s2, 12
    s_mov_b32 s62, 0x00ff00ff
    s_mov_b32 s63, 0xff00ff00
    s_waitcnt vmcnt(8)
    v_lshlrev_b32 v24, 16, v16
    v_and_b32 v25, s76, v16
    v_lshlrev_b32 v26, 16, v17
    v_and_b32 v27, s76, v17
    v_lshlrev_b32 v28, 16, v18
    v_and_b32 v29, s76, v18
    v_lshlrev_b32 v30, 16, v19
    v_and_b32 v31, s76, v19
    v_lshlrev_b32 v32, 16, v20
    v_and_b32 v33, s76, v20
    v_lshlrev_b32 v34, 16, v21
    v_and_b32 v35, s76, v21
    v_lshlrev_b32 v36, 16, v22
    v_and_b32 v37, s76, v22
    v_lshlrev_b32 v38, 16, v23
    v_and_b32 v39, s76, v23
    v_pk_add_f32 v[40:41], v[24:25], v[26:27]
    v_pk_add_f32 v[42:43], v[28:29], v[30:31]
    v_pk_add_f32 v[44:45], v[32:33], v[34:35]
    v_pk_add_f32 v[46:47], v[36:37], v[38:39]
    v_pk_add_f32 v[40:41], v[40:41], v[42:43]
    v_pk_add_f32 v[44:45], v[44:45], v[46:47]
    v_pk_add_f32 v[40:41], v[40:41], v[44:45]
    v_add_f32 v40, v40, v41
    s_nop 1
    v_add_f32_dpp v40, v40, v40 row_ror:8 row_mask:0xf bank_mask:0xf
    s_nop 1
    v_add_f32_dpp v40, v40, v40 row_ror:4 row_mask:0xf bank_mask:0xf
    s_nop 1
    v_add_f32_dpp v40, v40, v40 row_ror:2 row_mask:0xf bank_mask:0xf
    s_nop 1
    v_add_f32_dpp v40, v40, v40 row_ror:1 row_mask:0xf bank_mask:0xf
    v_mov_b32 v19, v40
    s_nop 1
    v_permlane16_swap_b32 v40, v19
    v_add_f32 v40, v40, v19
    v_mul_f32 v16, 0xbb000000, v40
    v_pk_add_f32 v[80:81], v[24:25], v[16:17] op_sel_hi:[1,0]
    v_pk_add_f32 v[82:83], v[26:27], v[16:17] op_sel_hi:[1,0]
    v_pk_add_f32 v[84:85], v[28:29], v[16:17] op_sel_hi:[1,0]
    v_pk_add_f32 v[86:87], v[30:31], v[16:17] op_sel_hi:[1,0]
    v_pk_add_f32 v[88:89], v[32:33], v[16:17] op_sel_hi:[1,0]
    v_pk_add_f32 v[90:91], v[34:35], v[16:17] op_sel_hi:[1,0]
    v_pk_add_f32 v[92:93], v[36:37], v[16:17] op_sel_hi:[1,0]
    v_pk_add_f32 v[94:95], v[38:39], v[16:17] op_sel_hi:[1,0]
    v_pk_mul_f32 v[40:41], v[80:81], v[80:81]
    v_pk_mul_f32 v[42:43], v[82:83], v[82:83]
    v_pk_fma_f32 v[40:41], v[84:85], v[84:85], v[40:41]
    v_pk_fma_f32 v[42:43], v[86:87], v[86:87], v[42:43]
    v_pk_fma_f32 v[40:41], v[88:89], v[88:89], v[40:41]
    v_pk_fma_f32 v[42:43], v[90:91], v[90:91], v[42:43]
    v_pk_fma_f32 v[40:41], v[92:93], v[92:93], v[40:41]
    v_pk_fma_f32 v[42:43], v[94:95], v[94:95], v[42:43]
    v_pk_add_f32 v[40:41], v[40:41], v[42:43]
    v_add_f32 v40, v40, v41
    s_nop 1
    v_add_f32_dpp v40, v40, v40 row_ror:8 row_mask:0xf bank_mask:0xf
    s_nop 1
    v_add_f32_dpp v40, v40, v40 row_ror:4 row_mask:0xf bank_mask:0xf
    s_nop 1
    v_add_f32_dpp v40, v40, v40 row_ror:2 row_mask:0xf bank_mask:0xf
    s_nop 1
    v_add_f32_dpp v40, v40, v40 row_ror:1 row_mask:0xf bank_mask:0xf
    v_mov_b32 v19, v40
    s_nop 1
    v_permlane16_swap_b32 v40, v19
    v_add_f32 v40, v40, v19
    v_mul_f32 v18, 0x3b000000, v40
    v_cvt_pk_bf16_f32 v16, v16, v16
    v_lshlrev_b32 v16, 16, v16
    v_cvt_pk_bf16_f32 v18, v18, v18
    v_lshlrev_b32 v18, 16, v18
    v_pk_add_f32 v[80:81], v[24:25], v[16:17] op_sel_hi:[1,0]
    v_pk_add_f32 v[82:83], v[26:27], v[16:17] op_sel_hi:[1,0]
    v_pk_add_f32 v[84:85], v[28:29], v[16:17] op_sel_hi:[1,0]
    v_pk_add_f32 v[86:87], v[30:31], v[16:17] op_sel_hi:[1,0]
    v_pk_add_f32 v[88:89], v[32:33], v[16:17] op_sel_hi:[1,0]
    v_pk_add_f32 v[90:91], v[34:35], v[16:17] op_sel_hi:[1,0]
    v_pk_add_f32 v[92:93], v[36:37], v[16:17] op_sel_hi:[1,0]
    v_pk_add_f32 v[94:95], v[38:39], v[16:17] op_sel_hi:[1,0]
    v_add_f32 v18, 0x3727c5ac, v18
    v_cvt_pk_bf16_f32 v18, v18, v18
    v_lshlrev_b32 v18, 16, v18
    v_cvt_pk_bf16_f32 v40, v80, v81
    v_cvt_pk_bf16_f32 v41, v82, v83
    v_cvt_pk_bf16_f32 v42, v84, v85
    v_cvt_pk_bf16_f32 v43, v86, v87
    v_cvt_pk_bf16_f32 v44, v88, v89
    v_cvt_pk_bf16_f32 v45, v90, v91
    v_cvt_pk_bf16_f32 v46, v92, v93
    v_cvt_pk_bf16_f32 v47, v94, v95
    v_sqrt_f32 v18, v18
    s_nop 0
    v_cvt_pk_bf16_f32 v18, v18, v18
    v_lshlrev_b32 v18, 16, v18
    v_rcp_f32 v20, v18
    v_lshlrev_b32 v80, 16, v40
    v_and_b32 v81, s76, v40
    v_lshlrev_b32 v82, 16, v41
    v_and_b32 v83, s76, v41
    v_lshlrev_b32 v84, 16, v42
    v_and_b32 v85, s76, v42
    v_lshlrev_b32 v86, 16, v43
    v_and_b32 v87, s76, v43
    v_lshlrev_b32 v88, 16, v44
    v_and_b32 v89, s76, v44
    v_lshlrev_b32 v90, 16, v45
    v_and_b32 v91, s76, v45
    v_lshlrev_b32 v92, 16, v46
    v_and_b32 v93, s76, v46
    v_lshlrev_b32 v94, 16, v47
    v_and_b32 v95, s76, v47
    v_pk_mul_f32 v[80:81], v[80:81], v[20:21] op_sel_hi:[1,0]
    v_pk_mul_f32 v[82:83], v[82:83], v[20:21] op_sel_hi:[1,0]
    v_pk_mul_f32 v[84:85], v[84:85], v[20:21] op_sel_hi:[1,0]
    v_pk_mul_f32 v[86:87], v[86:87], v[20:21] op_sel_hi:[1,0]
    v_pk_mul_f32 v[88:89], v[88:89], v[20:21] op_sel_hi:[1,0]
    v_pk_mul_f32 v[90:91], v[90:91], v[20:21] op_sel_hi:[1,0]
    v_pk_mul_f32 v[92:93], v[92:93], v[20:21] op_sel_hi:[1,0]
    v_pk_mul_f32 v[94:95], v[94:95], v[20:21] op_sel_hi:[1,0]
    v_cvt_pk_bf16_f32 v96, v80, v81
    v_cvt_pk_bf16_f32 v97, v82, v83
    v_cvt_pk_bf16_f32 v98, v84, v85
    v_cvt_pk_bf16_f32 v99, v86, v87
    v_cvt_pk_bf16_f32 v100, v88, v89
    v_cvt_pk_bf16_f32 v101, v90, v91
    v_cvt_pk_bf16_f32 v102, v92, v93
    v_cvt_pk_bf16_f32 v103, v94, v95
    ds_write_b128 v6, v[96:99]
    ds_write_b128 v6, v[100:103] offset:512
    s_waitcnt lgkmcnt(0)
    s_mov_b64 exec, 1
    ds_add_u32 v191, v1 offset:9728
    s_mov_b64 exec, -1
    s_load_dword s54, s[32:33], 0
    s_waitcnt vmcnt(6)
    v_perm_b32 v80, v52, v48, s56
    v_perm_b32 v84, v52, v48, s57
    v_perm_b32 v88, v53, v49, s56
    v_perm_b32 v92, v53, v49, s57
    v_perm_b32 v96, v54, v50, s56
    v_perm_b32 v100, v54, v50, s57
    v_perm_b32 v104, v55, v51, s56
    v_perm_b32 v108, v55, v51, s57
    s_waitcnt vmcnt(4)
    v_perm_b32 v81, v60, v56, s56
    v_perm_b32 v85, v60, v56, s57
    v_perm_b32 v89, v61, v57, s56
    v_perm_b32 v93, v61, v57, s57
    v_perm_b32 v97, v62, v58, s56
    v_perm_b32 v101, v62, v58, s57
    v_perm_b32 v105, v63, v59, s56
    v_perm_b32 v109, v63, v59, s57
    s_waitcnt vmcnt(2)
    v_perm_b32 v82, v68, v64, s56
    v_perm_b32 v86, v68, v64, s57
    v_perm_b32 v90, v69, v65, s56
    v_perm_b32 v94, v69, v65, s57
    v_perm_b32 v98, v70, v66, s56
    v_perm_b32 v102, v70, v66, s57
    v_perm_b32 v106, v71, v67, s56
    v_perm_b32 v110, v71, v67, s57
    s_waitcnt vmcnt(0)
    v_perm_b32 v83, v76, v72, s56
    v_perm_b32 v87, v76, v72, s57
    v_perm_b32 v91, v77, v73, s56
    v_perm_b32 v95, v77, v73, s57
    v_perm_b32 v99, v78, v74, s56
    v_perm_b32 v103, v78, v74, s57
    v_perm_b32 v107, v79, v75, s56
    v_perm_b32 v111, v79, v75, s57
    s_mov_b32 s59, 100000
L_fw_1:
    ds_read_b32 v3, v191 offset:9728
    s_waitcnt lgkmcnt(0)
    v_readfirstlane_b32 s66, v3
    s_nop 0
    s_cmp_ge_u32 s66, 4
    s_cbranch_scc1 L_fwd_2
    s_sub_u32 s59, s59, 1
    s_cbranch_scc0 L_fw_1
L_fwd_2:
    ds_read_b128 v[176:179], v168
    s_waitcnt lgkmcnt(0)
    v_mfma_f32_16x16x32_bf16 v[112:115], v[176:179], v[80:83], 0
    v_mfma_f32_16x16x32_bf16 v[116:119], v[176:179], v[84:87], 0
    v_mfma_f32_16x16x32_bf16 v[120:123], v[176:179], v[88:91], 0
    v_mfma_f32_16x16x32_bf16 v[124:127], v[176:179], v[92:95], 0
    v_mfma_f32_16x16x32_bf16 v[128:131], v[176:179], v[96:99], 0
    v_mfma_f32_16x16x32_bf16 v[132:135], v[176:179], v[100:103], 0
    v_mfma_f32_16x16x32_bf16 v[136:139], v[176:179], v[104:107], 0
    v_mfma_f32_16x16x32_bf16 v[140:143], v[176:179], v[108:111], 0
    s_cmp_lg_u32 s54, 0
    s_cbranch_scc1 L_nonce_ok
    s_load_dword s54, s[32:33], 64
    s_waitcnt lgkmcnt(0)
    s_cmp_lg_u32 s54, 0
    s_cbranch_scc1 L_nonce_ok
    s_load_dword s54, s[32:33], 128
    s_waitcnt lgkmcnt(0)
    s_cmp_lg_u32 s54, 0
    s_cbranch_scc1 L_nonce_ok
    s_load_dword s54, s[32:33], 192
    s_waitcnt lgkmcnt(0)
    s_mov_b32 s59, 20000
L_nonce:
    s_cmp_lg_u32 s54, 0
    s_cbranch_scc1 L_nonce_ok
    s_sub_u32 s59, s59, 1
    s_cbranch_scc1 L_nonce_ok
    buffer_load_dword v190, v191, s[32:35], 0 offen sc1
    s_waitcnt vmcnt(0)
    v_readfirstlane_b32 s54, v190
    s_branch L_nonce
L_nonce_ok:
    s_xor_b32 s55, s54, 0x5bd1e995
    v_mov_b32 v10, s54
    v_mov_b32 v11, s55
    v_mov_b32 v15, s54
    ds_write_b64 v191, v[10:11] offset:9920
    s_mov_b64 exec, s[62:63]
    ds_write_b128 v184, v[112:115] offset:0
    ds_write_b128 v184, v[116:119] offset:1024
    ds_write_b128 v184, v[120:123] offset:2048
    ds_write_b128 v184, v[124:127] offset:3072
    ds_write_b128 v184, v[128:131] offset:4096
    ds_write_b128 v184, v[132:135] offset:5120
    ds_write_b128 v184, v[136:139] offset:6144
    ds_write_b128 v184, v[140:143] offset:7168
    s_mov_b64 exec, -1
    s_waitcnt lgkmcnt(0)
    s_mov_b64 exec, 1
    ds_add_u32 v191, v1 offset:9732
    s_mov_b64 exec, -1
    s_lshl_b32 s70, s42, 12
    s_lshr_b32 s68, s43, 2
    s_lshl_b32 s68, s68, 9
    s_add_u32 s70, s70, s68
    s_add_u32 s48, s70, 32768
    s_mov_b32 s59, 100000
L_fw_3:
    ds_read_b32 v3, v191 offset:9732
    s_waitcnt lgkmcnt(0)
    v_readfirstlane_b32 s66, v3
    s_nop 0
    s_cmp_ge_u32 s66, 4
    s_cbranch_scc1 L_fwd_4
    s_sub_u32 s59, s59, 1
    s_cbranch_scc0 L_fw_3
L_fwd_4:
    v_add_u32 v3, 1024, v185
    ds_read2_b32 v[80:81], v185 offset0:0 offset1:32
    ds_read2_b32 v[82:83], v185 offset0:64 offset1:96
    ds_read2_b32 v[84:85], v185 offset0:128 offset1:160
    ds_read2_b32 v[86:87], v185 offset0:192 offset1:224
    ds_read2_b32 v[88:89], v3 offset0:0 offset1:32
    ds_read2_b32 v[90:91], v3 offset0:64 offset1:96
    ds_read2_b32 v[92:93], v3 offset0:128 offset1:160
    ds_read2_b32 v[94:95], v3 offset0:192 offset1:224
    s_waitcnt lgkmcnt(4)
    v_pk_add_f32 v[80:81], v[80:81], v[82:83]
    v_pk_add_f32 v[84:85], v[84:85], v[86:87]
    v_pk_add_f32 v[80:81], v[80:81], v[84:85]
    s_waitcnt lgkmcnt(0)
    v_add_f32 v8, v80, v81
    v_pk_add_f32 v[88:89], v[88:89], v[90:91]
    v_pk_add_f32 v[92:93], v[92:93], v[94:95]
    v_pk_add_f32 v[88:89], v[88:89], v[92:93]
    v_add_f32 v9, v88, v89
    buffer_store_dwordx4 v[8:11], v183, s[36:39], s58 offen
    s_lshr_b32 s67, s43, 3
    s_lshl_b32 s71, s67, 5
    s_add_u32 s71, s71, s42
    s_lshl_b32 s71, s71, 12
    s_add_u32 s71, s71, 0x80000
    s_lshl_b32 s79, s2, 11
    s_add_u32 s79, s79, 0x300000
    v_lshrrev_b32 v3, 5, v0
    s_lshl_b32 s66, s3, 1
    v_add_u32 v3, s66, v3
    v_and_b32 v4, 31, v0
    v_lshlrev_b32 v5, 16, v3
    v_lshl_add_u32 v182, v4, 4, v5
    v_lshlrev_b32 v3, 7, v3
    v_and_b32 v5, 7, v0
    v_lshl_add_u32 v3, v5, 4, v3
    v_bfe_u32 v5, v0, 3, 2
    v_lshl_add_u32 v6, v5, 2, v3
    s_add_u32 s40, s71, 32768
    s_add_u32 s41, s71, 65536
    s_add_u32 s44, s71, 98304
    v_bfe_u32 v5, v0, 3, 1
    v_lshrrev_b32 v4, 4, v0
    v_and_b32 v3, 7, v0
    v_lshlrev_b32 v179, 3, v3
    v_lshl_add_u32 v178, v4, 1, v179
    v_add_u32 v178, v178, v5
    v_lshlrev_b32 v178, 2, v178
    s_mov_b32 s59, 100000
L_fw_5:
    ds_read_b32 v3, v191 offset:9760
    s_waitcnt lgkmcnt(0)
    v_readfirstlane_b32 s66, v3
    s_nop 0
    s_cmp_ge_u32 s66, 4
    s_cbranch_scc1 L_fwd_6
    s_sleep 1
    s_sub_u32 s59, s59, 1
    s_cbranch_scc0 L_fw_5
L_fwd_6:
    buffer_load_dwordx4 v[80:83], v182, s[36:39], s70 offen nt
    buffer_load_dwordx4 v[84:87], v182, s[36:39], s48 offen nt
    buffer_load_dwordx4 v[144:147], v183, s[36:39], s71 offen nt
    buffer_load_dwordx4 v[148:151], v183, s[36:39], s40 offen nt
    buffer_load_dwordx4 v[152:155], v183, s[36:39], s41 offen nt
    buffer_load_dwordx4 v[156:159], v183, s[36:39], s44 offen nt
    s_waitcnt vmcnt(4)
    s_mov_b32 s59, 40000
L_q_chk:
    v_cmp_eq_u64 s[8:9], s[54:55], v[82:83]
    v_cmp_eq_u64 s[10:11], s[54:55], v[86:87]
    s_nop 0
    s_and_b64 s[60:61], s[8:9], s[10:11]
    s_cmp_eq_u64 s[60:61], -1
    s_cbranch_scc1 L_q_ok
    s_sub_u32 s59, s59, 1
    s_cbranch_scc1 L_q_ok
    s_cmp_gt_u32 s59, 39992
    s_cbranch_scc1 L_ny_7
    buffer_wbl2 sc1
    s_waitcnt vmcnt(0)
L_ny_7:
    s_andn2_b64 exec, -1, s[8:9]
    s_cbranch_execz L_sk_8
    buffer_load_dwordx4 v[80:83], v182, s[36:39], s70 offen sc1
L_sk_8:
    s_andn2_b64 exec, -1, s[10:11]
    s_cbranch_execz L_sk_9
    buffer_load_dwordx4 v[84:87], v182, s[36:39], s48 offen sc1
L_sk_9:
    s_mov_b64 exec, -1
    s_waitcnt vmcnt(0)
    s_branch L_q_chk
L_q_ok:
    v_add_f32 v80, v80, v84
    v_add_f32 v81, v81, v85
    v_cvt_pk_bf16_f32 v80, v80, v81
    ds_write_b32 v6, v80 offset:8704
    s_waitcnt lgkmcnt(0)
    s_mov_b64 exec, 1
    ds_add_u32 v191, v1 offset:9736
    s_mov_b64 exec, -1
    s_waitcnt vmcnt(0)
    s_mov_b32 s59, 40000
L_h_chk:
    v_cmp_eq_u64 s[8:9], s[54:55], v[146:147]
    v_cmp_eq_u64 s[10:11], s[54:55], v[150:151]
    v_cmp_eq_u64 s[12:13], s[54:55], v[154:155]
    v_cmp_eq_u64 s[14:15], s[54:55], v[158:159]
    s_and_b64 s[60:61], s[8:9], s[10:11]
    s_and_b64 s[60:61], s[60:61], s[12:13]
    s_and_b64 s[60:61], s[60:61], s[14:15]
    s_cmp_eq_u64 s[60:61], -1
    s_cbranch_scc1 L_h_ok
    s_sub_u32 s59, s59, 1
    s_cbranch_scc1 L_h_ok
    s_cmp_gt_u32 s59, 39992
    s_cbranch_scc1 L_ny_10
    buffer_wbl2 sc1
    s_waitcnt vmcnt(0)
L_ny_10:
    s_andn2_b64 exec, -1, s[8:9]
    s_cbranch_execz L_sk_11
    buffer_load_dwordx4 v[144:147], v183, s[36:39], s71 offen sc1
L_sk_11:
    s_andn2_b64 exec, -1, s[10:11]
    s_cbranch_execz L_sk_12
    buffer_load_dwordx4 v[148:151], v183, s[36:39], s40 offen sc1
L_sk_12:
    s_andn2_b64 exec, -1, s[12:13]
    s_cbranch_execz L_sk_13
    buffer_load_dwordx4 v[152:155], v183, s[36:39], s41 offen sc1
L_sk_13:
    s_andn2_b64 exec, -1, s[14:15]
    s_cbranch_execz L_sk_14
    buffer_load_dwordx4 v[156:159], v183, s[36:39], s44 offen sc1
L_sk_14:
    s_mov_b64 exec, -1
    s_waitcnt vmcnt(0)
    s_branch L_h_chk
L_h_ok:
    v_pk_add_f32 v[80:81], v[144:145], v[148:149]
    v_pk_add_f32 v[82:83], v[152:153], v[156:157]
    v_cvt_pk_bf16_f32 v84, v80, v81
    v_lshlrev_b32 v80, 16, v84
    v_and_b32 v81, s76, v84
    v_cvt_pk_bf16_f32 v85, v82, v83
    v_lshlrev_b32 v82, 16, v85
    v_and_b32 v83, s76, v85
    s_mov_b32 s67, 0xbdd2d3e8
    v_mov_b32 v88, 0xc0135761
    v_mul_f32 v86, v80, v80
    v_mul_f32 v87, v81, v81
    v_fma_f32 v86, v86, s67, v88
    v_fma_f32 v87, v87, s67, v88
    v_mul_f32 v86, v86, v80
    v_mul_f32 v87, v87, v81
    v_exp_f32 v86, v86
    v_exp_f32 v87, v87
    v_add_f32 v86, 1.0, v86
    v_add_f32 v87, 1.0, v87
    v_rcp_f32 v86, v86
    v_rcp_f32 v87, v87
    v_mul_f32 v80, v80, v86
    v_mul_f32 v81, v81, v87
    v_cvt_pk_bf16_f32 v84, v80, v81
    v_lshlrev_b32 v80, 16, v84
    v_and_b32 v81, s76, v84
    v_mul_f32 v80, v80, v82
    v_mul_f32 v81, v81, v83
    v_cvt_pk_bf16_f32 v180, v80, v81
    ds_bpermute_b32 v180, v178, v180
    v_mov_b32 v181, 0
    s_and_b32 s66, s43, 7
    s_lshr_b32 s67, s43, 3
    s_lshl_b32 s68, s67, 3
    s_add_u32 s68, s68, s42
    s_lshl_b32 s77, s66, 5
    s_add_u32 s77, s77, s68
    s_lshl_b32 s77, s77, 12
    s_add_u32 s77, s77, 0x100000
    s_lshl_b32 s53, s68, 5
    s_add_u32 s53, s53, s3
    s_lshl_b32 s53, s53, 11
    s_lshl_b32 s66, s66, 7
    s_add_u32 s53, s53, s66
    v_and_b32 v4, 7, v0
    v_and_b32 v188, 0x38, v0
    v_lshlrev_b32 v188, 10, v188
    v_lshl_add_u32 v188, v4, 4, v188
    s_mov_b32 s59, 100000
L_fw_15:
    ds_read_b32 v3, v191 offset:9740
    s_waitcnt lgkmcnt(0)
    v_readfirstlane_b32 s66, v3
    s_nop 0
    s_cmp_ge_u32 s66, 4
    s_cbranch_scc1 L_fwd_16
    s_sleep 1
    s_sub_u32 s59, s59, 1
    s_cbranch_scc0 L_fw_15
L_fwd_16:
    buffer_load_dwordx4 v[160:163], v188, s[24:27], s53 offen offset:0 nt
    buffer_load_dwordx4 v[164:167], v188, s[24:27], s53 offen offset:1024 nt
    v_and_b32 v3, 7, v0
    v_and_b32 v4, 1, v0
    v_mul_u32_u24 v182, 4160, v4
    v_bfe_u32 v4, v0, 1, 2
    v_lshl_add_u32 v182, v4, 4, v182
    v_bfe_u32 v5, v0, 3, 2
    v_lshl_add_u32 v182, v5, 2, v182
    s_lshl_b32 s66, s3, 6
    s_add_u32 s66, s66, 10240
    v_add_u32 v182, s66, v182
    v_lshlrev_b32 v6, 9, v5
    v_lshl_add_u32 v6, v3, 4, v6
    s_lshl_b32 s66, s3, 7
    v_add_u32 v6, s66, v6
    v_lshlrev_b32 v189, 5, v5
    s_lshl_b32 s66, s42, 10
    s_and_b32 s67, s43, 7
    s_lshl_b32 s68, s67, 7
    s_add_u32 s66, s66, s68
    s_lshr_b32 s68, s43, 3
    s_lshl_b32 s68, s68, 2
    s_add_u32 s66, s66, s68
    v_lshlrev_b32 v186, 4, v3
    v_add_u32 v186, s66, v186
    buffer_load_dword v7, v186, s[4:7], 0 offen
    v_lshrrev_b32 v190, 3, v0
    v_lshlrev_b32 v190, 12, v190
    v_lshl_add_u32 v190, v3, 4, v190
    s_lshl_b32 s66, s67, 17
    s_lshl_b32 s67, s42, 9
    s_add_u32 s66, s66, s67
    s_lshr_b32 s67, s43, 3
    s_lshl_b32 s67, s67, 7
    s_add_u32 s66, s66, s67
    s_add_u32 s48, s66, 0x200000
    s_add_u32 s72, s66, 0x100000
    s_add_u32 s49, s66, 0x208000
    s_add_u32 s78, s66, 0x108000
    s_add_u32 s50, s66, 0x210000
    s_add_u32 s52, s66, 0x110000
    s_add_u32 s51, s66, 0x218000
    s_add_u32 s45, s66, 0x118000
    v_mov_b32 v49, 0
    v_mov_b32 v51, 0
    v_mov_b32 v53, 0
    v_mov_b32 v55, 0
    v_mov_b32 v57, 0
    v_mov_b32 v59, 0
    v_mov_b32 v61, 0
    v_mov_b32 v63, 0
    s_mov_b32 s59, 100000
L_fw_17:
    ds_read_b32 v3, v191 offset:9744
    s_waitcnt lgkmcnt(0)
    v_readfirstlane_b32 s66, v3
    s_nop 0
    s_cmp_ge_u32 s66, 4
    s_cbranch_scc1 L_fwd_18
    s_sleep 1
    s_sub_u32 s59, s59, 1
    s_cbranch_scc0 L_fw_17
L_fwd_18:
    ds_read_b128 v[112:115], v189 offset:9792
    ds_read_b128 v[116:119], v189 offset:9808
    s_waitcnt lgkmcnt(0)
    v_max3_f32 v120, v112, v113, v114
    v_max_f32 v120, v120, v115
    v_sub_f32 v168, v112, v120
    v_sub_f32 v169, v113, v120
    v_sub_f32 v170, v114, v120
    v_sub_f32 v171, v115, v120
    v_exp_f32 v168, v168
    v_exp_f32 v169, v169
    v_exp_f32 v170, v170
    v_exp_f32 v171, v171
    v_mul_f32 v121, v168, v116
    v_fmac_f32 v121, v169, v117
    v_fmac_f32 v121, v170, v118
    v_fmac_f32 v121, v171, v119
    v_log_f32 v122, v121
    v_rcp_f32 v121, v121
    v_add_f32 v14, v120, v122
    s_getreg_b32 s67, hwreg(HW_REG_XCC_ID, 0, 3)
    v_and_b32 v14, -8, v14
    v_or_b32 v14, s67, v14
    v_mul_f32 v168, v168, v121
    v_mul_f32 v169, v169, v121
    v_mul_f32 v170, v170, v121
    v_mul_f32 v171, v171, v121
    s_barrier
    ds_read_b32 v16, v182 offset:0
    ds_read_b32 v17, v182 offset:256
    ds_read_b32 v18, v182 offset:512
    ds_read_b32 v19, v182 offset:768
    ds_read_b32 v20, v182 offset:1040
    ds_read_b32 v21, v182 offset:1296
    ds_read_b32 v22, v182 offset:1552
    ds_read_b32 v23, v182 offset:1808
    ds_read_b32 v24, v182 offset:2080
    ds_read_b32 v25, v182 offset:2336
    ds_read_b32 v26, v182 offset:2592
    ds_read_b32 v27, v182 offset:2848
    ds_read_b32 v28, v182 offset:3120
    ds_read_b32 v29, v182 offset:3376
    ds_read_b32 v30, v182 offset:3632
    ds_read_b32 v31, v182 offset:3888
    s_waitcnt lgkmcnt(12)
    v_mul_f32 v16, v16, v168
    v_fmac_f32 v16, v17, v169
    v_fmac_f32 v16, v18, v170
    v_fmac_f32 v16, v19, v171
    s_waitcnt lgkmcnt(8)
    v_mul_f32 v20, v20, v168
    v_fmac_f32 v20, v21, v169
    v_fmac_f32 v20, v22, v170
    v_fmac_f32 v20, v23, v171
    s_waitcnt lgkmcnt(4)
    v_mul_f32 v24, v24, v168
    v_fmac_f32 v24, v25, v169
    v_fmac_f32 v24, v26, v170
    v_fmac_f32 v24, v27, v171
    s_waitcnt lgkmcnt(0)
    v_mul_f32 v28, v28, v168
    v_fmac_f32 v28, v29, v169
    v_fmac_f32 v28, v30, v170
    v_fmac_f32 v28, v31, v171
    v_cvt_pk_bf16_f32 v12, v16, v20
    v_cvt_pk_bf16_f32 v13, v24, v28
    s_mov_b64 exec, 0xffffffff
    buffer_store_dwordx4 v[12:15], v6, s[36:39], s79 offen
    s_mov_b64 exec, -1
    s_waitcnt vmcnt(2)
    v_perm_b32 v48, v164, v160, s56
    v_perm_b32 v50, v164, v160, s57
    v_perm_b32 v52, v165, v161, s56
    v_perm_b32 v54, v165, v161, s57
    v_perm_b32 v56, v166, v162, s56
    v_perm_b32 v58, v166, v162, s57
    v_perm_b32 v60, v167, v163, s56
    v_perm_b32 v62, v167, v163, s57
    v_mfma_f32_16x16x16_bf16 v[112:115], v[180:181], v[48:49], 0
    v_mfma_f32_16x16x16_bf16 v[116:119], v[180:181], v[50:51], 0
    v_mfma_f32_16x16x16_bf16 v[120:123], v[180:181], v[52:53], 0
    v_mfma_f32_16x16x16_bf16 v[124:127], v[180:181], v[54:55], 0
    v_mfma_f32_16x16x16_bf16 v[128:131], v[180:181], v[56:57], 0
    v_mfma_f32_16x16x16_bf16 v[132:135], v[180:181], v[58:59], 0
    v_mfma_f32_16x16x16_bf16 v[136:139], v[180:181], v[60:61], 0
    v_mfma_f32_16x16x16_bf16 v[140:143], v[180:181], v[62:63], 0
    s_mov_b64 exec, s[62:63]
    ds_write_b128 v184, v[112:115] offset:0
    ds_write_b128 v184, v[116:119] offset:1024
    ds_write_b128 v184, v[120:123] offset:2048
    ds_write_b128 v184, v[124:127] offset:3072
    ds_write_b128 v184, v[128:131] offset:4096
    ds_write_b128 v184, v[132:135] offset:5120
    ds_write_b128 v184, v[136:139] offset:6144
    ds_write_b128 v184, v[140:143] offset:7168
    s_mov_b64 exec, -1
    s_waitcnt lgkmcnt(0)
    s_mov_b64 exec, 1
    ds_add_u32 v191, v1 offset:9752
    s_mov_b64 exec, -1
    s_mov_b32 s59, 100000
L_fw_19:
    ds_read_b32 v3, v191 offset:9752
    s_waitcnt lgkmcnt(0)
    v_readfirstlane_b32 s66, v3
    s_nop 0
    s_cmp_ge_u32 s66, 4
    s_cbranch_scc1 L_fwd_20
    s_sub_u32 s59, s59, 1
    s_cbranch_scc0 L_fw_19
L_fwd_20:
    v_add_u32 v3, 1024, v185
    ds_read2_b32 v[32:33], v185 offset0:0 offset1:32
    ds_read2_b32 v[34:35], v185 offset0:64 offset1:96
    ds_read2_b32 v[36:37], v185 offset0:128 offset1:160
    ds_read2_b32 v[38:39], v185 offset0:192 offset1:224
    ds_read2_b32 v[40:41], v3 offset0:0 offset1:32
    ds_read2_b32 v[42:43], v3 offset0:64 offset1:96
    ds_read2_b32 v[44:45], v3 offset0:128 offset1:160
    ds_read2_b32 v[46:47], v3 offset0:192 offset1:224
    s_waitcnt lgkmcnt(4)
    v_pk_add_f32 v[32:33], v[32:33], v[34:35]
    v_pk_add_f32 v[36:37], v[36:37], v[38:39]
    v_pk_add_f32 v[32:33], v[32:33], v[36:37]
    s_waitcnt lgkmcnt(0)
    v_add_f32 v8, v32, v33
    v_pk_add_f32 v[40:41], v[40:41], v[42:43]
    v_pk_add_f32 v[44:45], v[44:45], v[46:47]
    v_pk_add_f32 v[40:41], v[40:41], v[44:45]
    v_add_f32 v9, v40, v41
    s_mov_b32 s59, 100000
L_fw_21:
    ds_read_b32 v3, v191 offset:9772
    s_waitcnt lgkmcnt(0)
    v_readfirstlane_b32 s66, v3
    s_nop 0
    s_cmp_ge_u32 s66, 4
    s_cbranch_scc1 L_fwd_22
    s_sub_u32 s59, s59, 1
    s_cbranch_scc0 L_fw_21
L_fwd_22:
    buffer_store_dwordx4 v[8:11], v183, s[36:39], s77 offen sc1
    s_barrier
    s_cmp_lg_u32 s3, 0
    s_cbranch_scc1 L_fin
    v_mov_b32 v108, 0
    v_mov_b32 v109, 0
    v_mov_b32 v110, s54
    v_mov_b32 v111, s55
    buffer_load_dwordx4 v[96:99], v190, s[36:39], s72 offen sc1
    buffer_load_dwordx4 v[100:103], v190, s[36:39], s78 offen sc1
    buffer_load_dwordx4 v[104:107], v190, s[36:39], s52 offen sc1
    s_mov_b64 exec, 0xffffffff
    buffer_load_dwordx4 v[108:111], v190, s[36:39], s45 offen sc1
    s_mov_b64 exec, -1
    s_waitcnt vmcnt(0)
    s_mov_b32 s59, 200000
L_fg_chk:
    v_cmp_eq_u64 s[8:9], s[54:55], v[98:99]
    v_cmp_eq_u64 s[10:11], s[54:55], v[102:103]
    v_cmp_eq_u64 s[12:13], s[54:55], v[106:107]
    v_cmp_eq_u64 s[14:15], s[54:55], v[110:111]
    s_and_b64 s[60:61], s[8:9], s[10:11]
    s_and_b64 s[60:61], s[60:61], s[12:13]
    s_and_b64 s[60:61], s[60:61], s[14:15]
    s_cmp_eq_u64 s[60:61], -1
    s_cbranch_scc1 L_fg_ok
    s_sub_u32 s59, s59, 1
    s_cbranch_scc1 L_fg_ok
    s_andn2_b64 exec, -1, s[8:9]
    s_cbranch_execz L_sk_23
    buffer_load_dwordx4 v[96:99], v190, s[36:39], s72 offen sc1
L_sk_23:
    s_andn2_b64 exec, -1, s[10:11]
    s_cbranch_execz L_sk_24
    buffer_load_dwordx4 v[100:103], v190, s[36:39], s78 offen sc1
L_sk_24:
    s_andn2_b64 exec, -1, s[12:13]
    s_cbranch_execz L_sk_25
    buffer_load_dwordx4 v[104:107], v190, s[36:39], s52 offen sc1
L_sk_25:
    s_andn2_b64 exec, -1, s[14:15]
    s_cbranch_execz L_sk_26
    buffer_load_dwordx4 v[108:111], v190, s[36:39], s45 offen sc1
L_sk_26:
    s_mov_b64 exec, -1
    s_waitcnt vmcnt(0)
    s_branch L_fg_chk
L_fg_ok:
    buffer_load_dwordx4 v[80:83], v190, s[36:39], s48 offen sc1
    buffer_load_dwordx4 v[84:87], v190, s[36:39], s49 offen sc1
    buffer_load_dwordx4 v[88:91], v190, s[36:39], s50 offen sc1
    buffer_load_dwordx4 v[92:95], v190, s[36:39], s51 offen sc1
    v_pk_add_f32 v[96:97], v[96:97], v[100:101]
    v_pk_add_f32 v[104:105], v[104:105], v[108:109]
    v_pk_add_f32 v[96:97], v[96:97], v[104:105]
    s_nop 1
    v_add_f32_dpp v96, v96, v96 row_ror:8 row_mask:0xf bank_mask:0xf
    v_add_f32_dpp v97, v97, v97 row_ror:8 row_mask:0xf bank_mask:0xf
    v_mov_b32 v100, v96
    v_mov_b32 v101, v97
    s_nop 0
    v_permlane16_swap_b32 v96, v100
    v_permlane16_swap_b32 v97, v101
    v_add_f32 v96, v96, v100
    v_add_f32 v97, v97, v101
    v_mov_b32 v100, v96
    v_mov_b32 v101, v97
    s_nop 0
    v_permlane32_swap_b32 v96, v100
    v_permlane32_swap_b32 v97, v101
    v_add_f32 v96, v96, v100
    v_add_f32 v97, v97, v101
    v_cvt_pk_bf16_f32 v100, v96, v97
    v_lshlrev_b32 v96, 16, v100
    v_and_b32 v97, s76, v100
    s_mov_b32 s67, 0xbfb8aa3b
    v_mul_f32 v104, s67, v96
    v_mul_f32 v105, s67, v97
    v_exp_f32 v104, v104
    v_exp_f32 v105, v105
    v_add_f32 v104, 1.0, v104
    v_add_f32 v105, 1.0, v105
    v_rcp_f32 v104, v104
    v_rcp_f32 v105, v105
    v_mul_f32 v96, v96, v104
    v_mul_f32 v97, v97, v105
    v_cvt_pk_bf16_f32 v100, v96, v97
    v_lshlrev_b32 v96, 16, v100
    v_and_b32 v97, s76, v100
    v_lshlrev_b32 v104, 16, v7
    v_and_b32 v105, s76, v7
    s_waitcnt vmcnt(0)
    s_mov_b32 s59, 200000
L_fs_chk:
    v_cmp_eq_u64 s[8:9], s[54:55], v[82:83]
    v_cmp_eq_u64 s[10:11], s[54:55], v[86:87]
    v_cmp_eq_u64 s[12:13], s[54:55], v[90:91]
    v_cmp_eq_u64 s[14:15], s[54:55], v[94:95]
    s_and_b64 s[60:61], s[8:9], s[10:11]
    s_and_b64 s[60:61], s[60:61], s[12:13]
    s_and_b64 s[60:61], s[60:61], s[14:15]
    s_cmp_eq_u64 s[60:61], -1
    s_cbranch_scc1 L_fs_ok
    s_sub_u32 s59, s59, 1
    s_cbranch_scc1 L_fs_ok
    s_andn2_b64 exec, -1, s[8:9]
    s_cbranch_execz L_sk_27
    buffer_load_dwordx4 v[80:83], v190, s[36:39], s48 offen sc1
L_sk_27:
    s_andn2_b64 exec, -1, s[10:11]
    s_cbranch_execz L_sk_28
    buffer_load_dwordx4 v[84:87], v190, s[36:39], s49 offen sc1
L_sk_28:
    s_andn2_b64 exec, -1, s[12:13]
    s_cbranch_execz L_sk_29
    buffer_load_dwordx4 v[88:91], v190, s[36:39], s50 offen sc1
L_sk_29:
    s_andn2_b64 exec, -1, s[14:15]
    s_cbranch_execz L_sk_30
    buffer_load_dwordx4 v[92:95], v190, s[36:39], s51 offen sc1
L_sk_30:
    s_mov_b64 exec, -1
    s_waitcnt vmcnt(0)
    s_branch L_fs_chk
L_fs_ok:
    v_pk_add_f32 v[80:81], v[80:81], v[84:85]
    v_pk_add_f32 v[88:89], v[88:89], v[92:93]
    v_pk_add_f32 v[80:81], v[80:81], v[88:89]
    s_nop 1
    v_add_f32_dpp v80, v80, v80 row_ror:8 row_mask:0xf bank_mask:0xf
    v_add_f32_dpp v81, v81, v81 row_ror:8 row_mask:0xf bank_mask:0xf
    v_mov_b32 v84, v80
    v_mov_b32 v85, v81
    s_nop 0
    v_permlane16_swap_b32 v80, v84
    v_permlane16_swap_b32 v81, v85
    v_add_f32 v80, v80, v84
    v_add_f32 v81, v81, v85
    v_mov_b32 v84, v80
    v_mov_b32 v85, v81
    s_nop 0
    v_permlane32_swap_b32 v80, v84
    v_permlane32_swap_b32 v81, v85
    v_add_f32 v80, v80, v84
    v_add_f32 v81, v81, v85
    v_cvt_pk_bf16_f32 v84, v80, v81
    v_lshlrev_b32 v80, 16, v84
    v_and_b32 v81, s76, v84
    v_pk_mul_f32 v[80:81], v[80:81], v[96:97]
    v_cvt_pk_bf16_f32 v84, v80, v81
    v_lshlrev_b32 v80, 16, v84
    v_and_b32 v81, s76, v84
    v_pk_add_f32 v[80:81], v[80:81], v[104:105]
    v_cvt_pk_bf16_f32 v80, v80, v81
    s_mov_b64 exec, 0xff
    buffer_store_dword v80, v186, s[28:31], 0 offen
L_fin:
L_end:
    s_endpgm
L_A:
    v_lshlrev_b32 v2, 4, v0
    s_mov_b32 s14, 0x4000000
    s_mov_b32 s15, 0x00020000
    v_mov_b32 v191, 0
    v_mov_b32 v7, 1
    s_mov_b32 s56, 0x05040100
    s_mov_b32 s57, 0x07060302
    s_mov_b32 s73, 0x3e0293ee
    v_and_b32 v3, 3, v0
    v_lshlrev_b32 v182, 8, v3
    v_lshrrev_b32 v5, 4, v0
    v_lshl_add_u32 v182, v5, 6, v182
    v_bfe_u32 v5, v0, 2, 2
    v_lshl_add_u32 v182, v5, 4, v182
    v_lshlrev_b32 v183, 5, v3
    s_lshl_b32 s66, s3, 2
    v_add_u32 v183, s66, v183
    s_lshl_b32 s66, s3, 8
    s_add_u32 s66, s66, 10240
    v_add_u32 v184, s66, v2
    s_load_dwordx2 s[20:21], s[0:1], 32
    s_mov_b32 s22, 0x400000
    s_mov_b32 s23, 0x00020000
    s_mov_b32 s38, 0x400000
    s_mov_b32 s39, 0x00020000
    s_and_b32 s66, s43, 7
    s_lshr_b32 s67, s43, 3
    s_lshl_b32 s68, s42, 2
    s_add_u32 s68, s68, s67
    s_lshl_b32 s78, s66, 5
    s_add_u32 s78, s78, s68
    s_lshl_b32 s78, s78, 12
    s_add_u32 s78, s78, 0x200000
    s_lshl_b32 s52, s68, 2
    s_add_u32 s52, s52, s3
    s_lshl_b32 s52, s52, 15
    s_lshl_b32 s66, s66, 7
    s_add_u32 s52, s52, s66
    s_lshl_b32 s72, s42, 11
    s_lshl_b32 s68, s67, 9
    s_add_u32 s72, s72, s68
    s_add_u32 s72, s72, 0x300000
    s_add_u32 s44, s72, 16384
    s_add_u32 s45, s72, 32768
    s_add_u32 s46, s72, 49152
    s_mov_b32 s76, 0xffff0000
    v_bfe_u32 v5, v0, 3, 1
    v_lshrrev_b32 v4, 4, v0
    v_lshlrev_b32 v187, 2, v5
    v_add_u32 v187, v187, v4
    v_and_b32 v3, 7, v0
    v_lshlrev_b32 v187, 12, v187
    v_lshl_add_u32 v187, v3, 4, v187
    v_lshlrev_b32 v12, 3, v3
    v_lshl_add_u32 v12, v5, 2, v12
    v_add_u32 v12, v12, v4
    v_lshlrev_b32 v12, 2, v12
    v_lshrrev_b32 v186, 3, v0
    v_lshlrev_b32 v188, 16, v186
    v_lshl_add_u32 v188, v3, 4, v188
    v_lshlrev_b32 v186, 9, v186
    v_lshl_add_u32 v186, v3, 4, v186
    s_lshl_b32 s67, s3, 7
    v_add_u32 v186, s67, v186
    v_add_u32 v188, s67, v188
    v_bfe_u32 v189, v0, 4, 1
    v_lshlrev_b32 v189, 13, v189
    v_and_b32 v4, 15, v0
    v_lshl_add_u32 v189, v4, 4, v189
    s_lshl_b32 s67, s3, 8
    s_add_u32 s67, s67, 35072
    v_add_u32 v189, s67, v189
    v_lshrrev_b32 v190, 5, v0
    v_lshlrev_b32 v190, 13, v190
    v_lshl_add_u32 v190, v3, 4, v190
    v_bfe_u32 v4, v0, 3, 2
    v_lshl_add_u32 v190, v4, 2, v190
    s_lshl_b32 s67, s3, 11
    s_add_u32 s67, s67, 35072
    v_add_u32 v190, s67, v190
    s_mov_b32 s62, 0x00ff00ff
    s_mov_b32 s63, 0xff00ff00
    s_waitcnt lgkmcnt(0)
    s_waitcnt vmcnt(7)
    buffer_load_dwordx4 a[32:35], v1, s[8:11], s48 offen nt
    s_add_u32 s48, s48, 4096
    s_waitcnt vmcnt(7)
    buffer_load_dwordx4 a[36:39], v1, s[8:11], s48 offen nt
    s_add_u32 s48, s48, 4096
    s_waitcnt vmcnt(7)
    buffer_load_dwordx4 a[40:43], v1, s[8:11], s48 offen nt
    s_add_u32 s48, s48, 4096
    s_waitcnt vmcnt(7)
    buffer_load_dwordx4 a[44:47], v1, s[8:11], s48 offen nt
    s_add_u32 s48, s48, 4096
    s_waitcnt vmcnt(7)
    buffer_load_dwordx4 a[48:51], v1, s[8:11], s48 offen nt
    s_add_u32 s48, s48, 4096
    s_waitcnt vmcnt(7)
    buffer_load_dwordx4 a[52:55], v1, s[8:11], s48 offen nt
    s_add_u32 s48, s48, 4096
    s_waitcnt vmcnt(7)
    buffer_load_dwordx4 a[56:59], v1, s[8:11], s48 offen nt
    s_add_u32 s48, s48, 4096
    s_waitcnt vmcnt(7)
    buffer_load_dwordx4 a[60:63], v1, s[8:11], s48 offen nt
    s_mov_b64 exec, 1
    ds_add_u32 v191, v7 offset:9760
    s_mov_b64 exec, -1
    s_waitcnt vmcnt(7)
    buffer_load_dwordx4 v[16:19], v2, s[12:15], s49 offen nt
    s_add_u32 s49, s49, 4096
    s_waitcnt vmcnt(7)
    buffer_load_dwordx4 v[20:23], v2, s[12:15], s49 offen nt
    s_add_u32 s49, s49, 4096
    s_waitcnt vmcnt(7)
    buffer_load_dwordx4 v[24:27], v2, s[12:15], s49 offen nt
    s_add_u32 s49, s49, 4096
    s_waitcnt vmcnt(7)
    buffer_load_dwordx4 v[28:31], v2, s[12:15], s49 offen nt
    s_add_u32 s49, s49, 4096
    s_waitcnt vmcnt(7)
    buffer_load_dwordx4 v[32:35], v2, s[12:15], s49 offen nt
    s_add_u32 s49, s49, 4096
    s_waitcnt vmcnt(7)
    buffer_load_dwordx4 v[36:39], v2, s[12:15], s49 offen nt
    s_add_u32 s49, s49, 4096
    s_waitcnt vmcnt(7)
    buffer_load_dwordx4 v[40:43], v2, s[12:15], s49 offen nt
    s_add_u32 s49, s49, 4096
    s_waitcnt vmcnt(7)
    buffer_load_dwordx4 v[44:47], v2, s[12:15], s49 offen nt
    s_add_u32 s49, s49, 4096
    s_waitcnt vmcnt(7)
    buffer_load_dwordx4 v[48:51], v2, s[12:15], s49 offen nt
    s_add_u32 s49, s49, 4096
    s_waitcnt vmcnt(7)
    buffer_load_dwordx4 v[52:55], v2, s[12:15], s49 offen nt
    s_add_u32 s49, s49, 4096
    v_perm_b32 v80, v20, v16, s56
    v_perm_b32 v84, v20, v16, s57
    v_perm_b32 v88, v21, v17, s56
    v_perm_b32 v92, v21, v17, s57
    v_perm_b32 v96, v22, v18, s56
    v_perm_b32 v100, v22, v18, s57
    v_perm_b32 v104, v23, v19, s56
    v_perm_b32 v108, v23, v19, s57
    s_waitcnt vmcnt(7)
    buffer_load_dwordx4 v[56:59], v2, s[12:15], s49 offen nt
    s_add_u32 s49, s49, 4096
    s_waitcnt vmcnt(7)
    buffer_load_dwordx4 v[60:63], v2, s[12:15], s49 offen nt
    s_add_u32 s49, s49, 4096
    v_perm_b32 v81, v28, v24, s56
    v_perm_b32 v85, v28, v24, s57
    v_perm_b32 v89, v29, v25, s56
    v_perm_b32 v93, v29, v25, s57
    v_perm_b32 v97, v30, v26, s56
    v_perm_b32 v101, v30, v26, s57
    v_perm_b32 v105, v31, v27, s56
    v_perm_b32 v109, v31, v27, s57
    s_waitcnt vmcnt(7)
    buffer_load_dwordx4 v[64:67], v2, s[12:15], s49 offen nt
    s_add_u32 s49, s49, 4096
    s_waitcnt vmcnt(7)
    buffer_load_dwordx4 v[68:71], v2, s[12:15], s49 offen nt
    s_add_u32 s49, s49, 4096
    v_perm_b32 v82, v36, v32, s56
    v_perm_b32 v86, v36, v32, s57
    v_perm_b32 v90, v37, v33, s56
    v_perm_b32 v94, v37, v33, s57
    v_perm_b32 v98, v38, v34, s56
    v_perm_b32 v102, v38, v34, s57
    v_perm_b32 v106, v39, v35, s56
    v_perm_b32 v110, v39, v35, s57
    s_waitcnt vmcnt(7)
    buffer_load_dwordx4 v[72:75], v2, s[12:15], s49 offen nt
    s_add_u32 s49, s49, 4096
    s_waitcnt vmcnt(7)
    buffer_load_dwordx4 v[76:79], v2, s[12:15], s49 offen nt
    v_perm_b32 v83, v44, v40, s56
    v_perm_b32 v87, v44, v40, s57
    v_perm_b32 v91, v45, v41, s56
    v_perm_b32 v95, v45, v41, s57
    v_perm_b32 v99, v46, v42, s56
    v_perm_b32 v103, v46, v42, s57
    v_perm_b32 v107, v47, v43, s56
    v_perm_b32 v111, v47, v43, s57
    s_mov_b32 s59, 100000
L_fw_31:
    ds_read_b32 v3, v191 offset:9736
    s_waitcnt lgkmcnt(0)
    v_readfirstlane_b32 s66, v3
    s_nop 0
    s_cmp_ge_u32 s66, 4
    s_cbranch_scc1 L_fwd_32
    s_sleep 1
    s_sub_u32 s59, s59, 1
    s_cbranch_scc0 L_fw_31
L_fwd_32:
    ds_read_b128 v[168:171], v182 offset:8704
    ds_read_b64 v[10:11], v191 offset:9920
    s_waitcnt lgkmcnt(0)
    v_readfirstlane_b32 s54, v10
    v_mfma_f32_16x16x32_bf16 v[112:115], a[0:3], v[168:171], 0
    v_mfma_f32_16x16x32_bf16 v[116:119], a[16:19], v[168:171], 0
    v_mfma_f32_16x16x32_bf16 v[120:123], a[32:35], v[168:171], 0
    v_mfma_f32_16x16x32_bf16 v[124:127], a[48:51], v[168:171], 0
    v_mfma_f32_16x16x32_bf16 v[128:131], a[4:7], v[168:171], 0
    v_mfma_f32_16x16x32_bf16 v[132:135], a[20:23], v[168:171], 0
    v_mfma_f32_16x16x32_bf16 v[136:139], a[36:39], v[168:171], 0
    v_mfma_f32_16x16x32_bf16 v[140:143], a[52:55], v[168:171], 0
    s_nop 0
    v_add_f32_dpp v176, v113, v112 row_ror:12 row_mask:0xf bank_mask:0x1
    v_add_f32_dpp v177, v117, v116 row_ror:12 row_mask:0xf bank_mask:0x1
    v_add_f32_dpp v178, v121, v120 row_ror:12 row_mask:0xf bank_mask:0x1
    v_add_f32_dpp v179, v125, v124 row_ror:12 row_mask:0xf bank_mask:0x1
    v_add_f32_dpp v176, v114, v176 row_ror:8 row_mask:0xf bank_mask:0x1
    v_add_f32_dpp v177, v118, v177 row_ror:8 row_mask:0xf bank_mask:0x1
    v_add_f32_dpp v178, v122, v178 row_ror:8 row_mask:0xf bank_mask:0x1
    v_add_f32_dpp v179, v126, v179 row_ror:8 row_mask:0xf bank_mask:0x1
    v_add_f32_dpp v176, v115, v176 row_ror:4 row_mask:0xf bank_mask:0x1
    v_add_f32_dpp v177, v119, v177 row_ror:4 row_mask:0xf bank_mask:0x1
    v_add_f32_dpp v178, v123, v178 row_ror:4 row_mask:0xf bank_mask:0x1
    v_add_f32_dpp v179, v127, v179 row_ror:4 row_mask:0xf bank_mask:0x1
    v_mfma_f32_16x16x32_bf16 v[112:115], a[8:11], v[168:171], 0
    v_mfma_f32_16x16x32_bf16 v[116:119], a[24:27], v[168:171], 0
    v_mfma_f32_16x16x32_bf16 v[120:123], a[40:43], v[168:171], 0
    v_mfma_f32_16x16x32_bf16 v[124:127], a[56:59], v[168:171], 0
    v_add_f32_dpp v176, v130, v129 row_ror:12 row_mask:0xf bank_mask:0x2
    v_add_f32_dpp v177, v134, v133 row_ror:12 row_mask:0xf bank_mask:0x2
    v_add_f32_dpp v178, v138, v137 row_ror:12 row_mask:0xf bank_mask:0x2
    v_add_f32_dpp v179, v142, v141 row_ror:12 row_mask:0xf bank_mask:0x2
    v_add_f32_dpp v176, v131, v176 row_ror:8 row_mask:0xf bank_mask:0x2
    v_add_f32_dpp v177, v135, v177 row_ror:8 row_mask:0xf bank_mask:0x2
    v_add_f32_dpp v178, v139, v178 row_ror:8 row_mask:0xf bank_mask:0x2
    v_add_f32_dpp v179, v143, v179 row_ror:8 row_mask:0xf bank_mask:0x2
    v_add_f32_dpp v176, v128, v176 row_ror:4 row_mask:0xf bank_mask:0x2
    v_add_f32_dpp v177, v132, v177 row_ror:4 row_mask:0xf bank_mask:0x2
    v_add_f32_dpp v178, v136, v178 row_ror:4 row_mask:0xf bank_mask:0x2
    v_add_f32_dpp v179, v140, v179 row_ror:4 row_mask:0xf bank_mask:0x2
    v_mfma_f32_16x16x32_bf16 v[128:131], a[12:15], v[168:171], 0
    v_mfma_f32_16x16x32_bf16 v[132:135], a[28:31], v[168:171], 0
    v_mfma_f32_16x16x32_bf16 v[136:139], a[44:47], v[168:171], 0
    v_mfma_f32_16x16x32_bf16 v[140:143], a[60:63], v[168:171], 0
    v_add_f32_dpp v176, v115, v114 row_ror:12 row_mask:0xf bank_mask:0x4
    v_add_f32_dpp v177, v119, v118 row_ror:12 row_mask:0xf bank_mask:0x4
    v_add_f32_dpp v178, v123, v122 row_ror:12 row_mask:0xf bank_mask:0x4
    v_add_f32_dpp v179, v127, v126 row_ror:12 row_mask:0xf bank_mask:0x4
    v_add_f32_dpp v176, v112, v176 row_ror:8 row_mask:0xf bank_mask:0x4
    v_add_f32_dpp v177, v116, v177 row_ror:8 row_mask:0xf bank_mask:0x4
    v_add_f32_dpp v178, v120, v178 row_ror:8 row_mask:0xf bank_mask:0x4
    v_add_f32_dpp v179, v124, v179 row_ror:8 row_mask:0xf bank_mask:0x4
    v_add_f32_dpp v176, v113, v176 row_ror:4 row_mask:0xf bank_mask:0x4
    v_add_f32_dpp v177, v117, v177 row_ror:4 row_mask:0xf bank_mask:0x4
    v_add_f32_dpp v178, v121, v178 row_ror:4 row_mask:0xf bank_mask:0x4
    v_add_f32_dpp v179, v125, v179 row_ror:4 row_mask:0xf bank_mask:0x4
    v_add_f32_dpp v176, v128, v131 row_ror:12 row_mask:0xf bank_mask:0x8
    v_add_f32_dpp v177, v132, v135 row_ror:12 row_mask:0xf bank_mask:0x8
    v_add_f32_dpp v178, v136, v139 row_ror:12 row_mask:0xf bank_mask:0x8
    v_add_f32_dpp v179, v140, v143 row_ror:12 row_mask:0xf bank_mask:0x8
    v_add_f32_dpp v176, v129, v176 row_ror:8 row_mask:0xf bank_mask:0x8
    v_add_f32_dpp v177, v133, v177 row_ror:8 row_mask:0xf bank_mask:0x8
    v_add_f32_dpp v178, v137, v178 row_ror:8 row_mask:0xf bank_mask:0x8
    v_add_f32_dpp v179, v141, v179 row_ror:8 row_mask:0xf bank_mask:0x8
    v_add_f32_dpp v176, v130, v176 row_ror:4 row_mask:0xf bank_mask:0x8
    v_add_f32_dpp v177, v134, v177 row_ror:4 row_mask:0xf bank_mask:0x8
    v_add_f32_dpp v178, v138, v178 row_ror:4 row_mask:0xf bank_mask:0x8
    v_add_f32_dpp v179, v142, v179 row_ror:4 row_mask:0xf bank_mask:0x8
    v_max3_f32 v3, v176, v177, v178
    v_max_f32 v3, v3, v179
    s_nop 1
    v_max_f32_dpp v3, v3, v3 row_ror:4 row_mask:0xf bank_mask:0xf
    s_nop 1
    v_max_f32_dpp v3, v3, v3 row_ror:8 row_mask:0xf bank_mask:0xf
    v_mov_b32 v5, v3
    s_nop 1
    v_permlane16_swap_b32 v3, v5
    v_max_f32 v3, v3, v5
    v_mov_b32 v5, v3
    s_nop 1
    v_permlane32_swap_b32 v3, v5
    v_max_f32 v3, v3, v5
    v_mul_f32 v3, s73, v3
    v_fma_f32 v176, v176, s73, -v3
    v_fma_f32 v177, v177, s73, -v3
    v_fma_f32 v178, v178, s73, -v3
    v_fma_f32 v179, v179, s73, -v3
    v_exp_f32 v176, v176
    v_exp_f32 v177, v177
    v_exp_f32 v178, v178
    v_exp_f32 v179, v179
    v_mov_b32_dpp v112, v176 row_ror:12 row_mask:0xf bank_mask:0xf
    v_mov_b32_dpp v113, v177 row_ror:12 row_mask:0xf bank_mask:0xf
    v_mov_b32_dpp v114, v178 row_ror:12 row_mask:0xf bank_mask:0xf
    v_mov_b32_dpp v115, v179 row_ror:12 row_mask:0xf bank_mask:0xf
    v_add_f32 v4, v176, v177
    v_add_f32 v5, v178, v179
    v_cvt_pk_bf16_f32 v168, v176, v112
    v_cvt_pk_bf16_f32 v170, v177, v113
    v_cvt_pk_bf16_f32 v172, v178, v114
    v_cvt_pk_bf16_f32 v174, v179, v115
    v_add_f32 v4, v4, v5
    v_mov_b32_dpp v169, v168 row_ror:8 row_mask:0xf bank_mask:0xf
    v_mov_b32_dpp v171, v170 row_ror:8 row_mask:0xf bank_mask:0xf
    v_mov_b32_dpp v173, v172 row_ror:8 row_mask:0xf bank_mask:0xf
    v_mov_b32_dpp v175, v174 row_ror:8 row_mask:0xf bank_mask:0xf
    v_add_f32_dpp v4, v4, v4 row_ror:4 row_mask:0xf bank_mask:0xf
    s_nop 1
    v_add_f32_dpp v4, v4, v4 row_ror:8 row_mask:0xf bank_mask:0xf
    v_mov_b32 v5, v4
    s_nop 1
    v_permlane16_swap_b32 v4, v5
    v_add_f32 v4, v4, v5
    v_mov_b32 v5, v4
    s_nop 1
    v_permlane32_swap_b32 v4, v5
    v_add_f32 v4, v4, v5
    s_mov_b64 exec, 15
    ds_write_b32 v183, v3 offset:9792
    ds_write_b32 v183, v4 offset:9808
    s_mov_b64 exec, -1
    s_waitcnt lgkmcnt(0)
    s_mov_b64 exec, 1
    ds_add_u32 v191, v7 offset:9744
    s_mov_b64 exec, -1
    v_mfma_f32_16x16x32_bf16 v[112:115], v[168:171], v[80:83], 0
    v_mfma_f32_16x16x32_bf16 v[116:119], v[168:171], v[84:87], 0
    v_mfma_f32_16x16x32_bf16 v[120:123], v[168:171], v[88:91], 0
    v_mfma_f32_16x16x32_bf16 v[124:127], v[168:171], v[92:95], 0
    v_mfma_f32_16x16x32_bf16 v[128:131], v[168:171], v[96:99], 0
    v_mfma_f32_16x16x32_bf16 v[132:135], v[168:171], v[100:103], 0
    v_mfma_f32_16x16x32_bf16 v[136:139], v[168:171], v[104:107], 0
    v_mfma_f32_16x16x32_bf16 v[140:143], v[168:171], v[108:111], 0
    s_waitcnt vmcnt(6)
    v_perm_b32 v80, v52, v48, s56
    v_perm_b32 v84, v52, v48, s57
    v_perm_b32 v88, v53, v49, s56
    v_perm_b32 v92, v53, v49, s57
    v_perm_b32 v96, v54, v50, s56
    v_perm_b32 v100, v54, v50, s57
    v_perm_b32 v104, v55, v51, s56
    v_perm_b32 v108, v55, v51, s57
    s_waitcnt vmcnt(4)
    s_mov_b64 exec, 1
    ds_add_u32 v191, v7 offset:9740
    s_mov_b64 exec, -1
    buffer_load_dwordx4 v[144:147], v187, s[20:23], s52 offen offset:0 nt
    buffer_load_dwordx4 v[148:151], v187, s[20:23], s52 offen offset:1024 nt
    buffer_load_dwordx4 v[152:155], v187, s[20:23], s52 offen offset:2048 nt
    buffer_load_dwordx4 v[156:159], v187, s[20:23], s52 offen offset:3072 nt
    v_perm_b32 v81, v60, v56, s56
    v_perm_b32 v85, v60, v56, s57
    v_perm_b32 v89, v61, v57, s56
    v_perm_b32 v93, v61, v57, s57
    v_perm_b32 v97, v62, v58, s56
    v_perm_b32 v101, v62, v58, s57
    v_perm_b32 v105, v63, v59, s56
    v_perm_b32 v109, v63, v59, s57
    s_waitcnt vmcnt(6)
    v_perm_b32 v82, v68, v64, s56
    v_perm_b32 v86, v68, v64, s57
    v_perm_b32 v90, v69, v65, s56
    v_perm_b32 v94, v69, v65, s57
    v_perm_b32 v98, v70, v66, s56
    v_perm_b32 v102, v70, v66, s57
    v_perm_b32 v106, v71, v67, s56
    v_perm_b32 v110, v71, v67, s57
    s_waitcnt vmcnt(4)
    v_perm_b32 v83, v76, v72, s56
    v_perm_b32 v87, v76, v72, s57
    v_perm_b32 v91, v77, v73, s56
    v_perm_b32 v95, v77, v73, s57
    v_perm_b32 v99, v78, v74, s56
    v_perm_b32 v103, v78, v74, s57
    v_perm_b32 v107, v79, v75, s56
    v_perm_b32 v111, v79, v75, s57
    v_mfma_f32_16x16x32_bf16 v[112:115], v[172:175], v[80:83], v[112:115]
    v_mfma_f32_16x16x32_bf16 v[116:119], v[172:175], v[84:87], v[116:119]
    v_mfma_f32_16x16x32_bf16 v[120:123], v[172:175], v[88:91], v[120:123]
    v_mfma_f32_16x16x32_bf16 v[124:127], v[172:175], v[92:95], v[124:127]
    v_mfma_f32_16x16x32_bf16 v[128:131], v[172:175], v[96:99], v[128:131]
    v_mfma_f32_16x16x32_bf16 v[132:135], v[172:175], v[100:103], v[132:135]
    v_mfma_f32_16x16x32_bf16 v[136:139], v[172:175], v[104:107], v[136:139]
    v_mfma_f32_16x16x32_bf16 v[140:143], v[172:175], v[108:111], v[140:143]
    s_mov_b64 exec, 0xffff
    ds_write_b128 v184, v[112:115] offset:0
    ds_write_b128 v184, v[116:119] offset:1040
    ds_write_b128 v184, v[120:123] offset:2080
    ds_write_b128 v184, v[124:127] offset:3120
    ds_write_b128 v184, v[128:131] offset:4160
    ds_write_b128 v184, v[132:135] offset:5200
    ds_write_b128 v184, v[136:139] offset:6240
    ds_write_b128 v184, v[140:143] offset:7280
    s_waitcnt lgkmcnt(0)
    s_barrier
    s_mov_b64 exec, -1
    buffer_load_dwordx4 v[16:19], v188, s[36:39], s72 offen sc1
    buffer_load_dwordx4 v[20:23], v188, s[36:39], s44 offen sc1
    buffer_load_dwordx4 v[24:27], v188, s[36:39], s45 offen sc1
    buffer_load_dwordx4 v[28:31], v188, s[36:39], s46 offen sc1
    s_waitcnt vmcnt(4)
    v_perm_b32 v80, v148, v144, s56
    v_perm_b32 v82, v148, v144, s57
    v_perm_b32 v84, v149, v145, s56
    v_perm_b32 v86, v149, v145, s57
    v_perm_b32 v88, v150, v146, s56
    v_perm_b32 v90, v150, v146, s57
    v_perm_b32 v92, v151, v147, s56
    v_perm_b32 v94, v151, v147, s57
    v_perm_b32 v81, v156, v152, s56
    v_perm_b32 v83, v156, v152, s57
    v_perm_b32 v85, v157, v153, s56
    v_perm_b32 v87, v157, v153, s57
    v_perm_b32 v89, v158, v154, s56
    v_perm_b32 v91, v158, v154, s57
    v_perm_b32 v93, v159, v155, s56
    v_perm_b32 v95, v159, v155, s57
    s_waitcnt vmcnt(0)
    s_mov_b32 s59, 200000
L_g2_chk:
    v_cmp_eq_u32 s[8:9], s54, v19
    v_cmp_eq_u32 s[10:11], s54, v23
    v_cmp_eq_u32 s[12:13], s54, v27
    v_cmp_eq_u32 s[14:15], s54, v31
    s_and_b64 s[60:61], s[8:9], s[10:11]
    s_and_b64 s[60:61], s[60:61], s[12:13]
    s_and_b64 s[60:61], s[60:61], s[14:15]
    s_cmp_eq_u64 s[60:61], -1
    s_cbranch_scc1 L_g2_ok
    s_sub_u32 s59, s59, 1
    s_cbranch_scc1 L_g2_ok
    s_cmp_gt_u32 s59, 199936
    s_cbranch_scc1 L_ny_33
    buffer_wbl2 sc1
    s_waitcnt vmcnt(0)
L_ny_33:
    s_andn2_b64 exec, -1, s[8:9]
    s_cbranch_execz L_sk_34
    buffer_load_dwordx4 v[16:19], v188, s[36:39], s72 offen sc1
L_sk_34:
    s_andn2_b64 exec, -1, s[10:11]
    s_cbranch_execz L_sk_35
    buffer_load_dwordx4 v[20:23], v188, s[36:39], s44 offen sc1
L_sk_35:
    s_andn2_b64 exec, -1, s[12:13]
    s_cbranch_execz L_sk_36
    buffer_load_dwordx4 v[24:27], v188, s[36:39], s45 offen sc1
L_sk_36:
    s_andn2_b64 exec, -1, s[14:15]
    s_cbranch_execz L_sk_37
    buffer_load_dwordx4 v[28:31], v188, s[36:39], s46 offen sc1
L_sk_37:
    s_mov_b64 exec, -1
    s_waitcnt vmcnt(0)
    s_branch L_g2_chk
L_g2_ok:
    s_mov_b64 exec, 1
    ds_add_u32 v191, v7 offset:9772
    s_mov_b64 exec, -1
    v_max3_f32 v36, v18, v22, v26
    v_max_f32 v36, v36, v30
    v_sub_f32 v32, v18, v36
    v_sub_f32 v33, v22, v36
    v_sub_f32 v34, v26, v36
    v_sub_f32 v35, v30, v36
    v_exp_f32 v32, v32
    v_exp_f32 v33, v33
    v_exp_f32 v34, v34
    v_exp_f32 v35, v35
    v_lshlrev_b32 v44, 16, v16
    v_and_b32 v45, s76, v16
    v_lshlrev_b32 v46, 16, v17
    v_and_b32 v47, s76, v17
    v_add_f32 v36, v32, v33
    v_add_f32 v37, v34, v35
    v_add_f32 v36, v36, v37
    v_rcp_f32 v36, v36
    v_pk_mul_f32 v[40:41], v[44:45], v[32:33] op_sel:[0,0] op_sel_hi:[1,0]
    v_pk_mul_f32 v[42:43], v[46:47], v[32:33] op_sel:[0,0] op_sel_hi:[1,0]
    v_lshlrev_b32 v44, 16, v20
    v_and_b32 v45, s76, v20
    v_lshlrev_b32 v46, 16, v21
    v_and_b32 v47, s76, v21
    v_pk_fma_f32 v[40:41], v[44:45], v[32:33], v[40:41] op_sel:[0,1,0] op_sel_hi:[1,1,1]
    v_pk_fma_f32 v[42:43], v[46:47], v[32:33], v[42:43] op_sel:[0,1,0] op_sel_hi:[1,1,1]
    v_lshlrev_b32 v44, 16, v24
    v_and_b32 v45, s76, v24
    v_lshlrev_b32 v46, 16, v25
    v_and_b32 v47, s76, v25
    v_pk_fma_f32 v[40:41], v[44:45], v[34:35], v[40:41] op_sel:[0,0,0] op_sel_hi:[1,0,1]
    v_pk_fma_f32 v[42:43], v[46:47], v[34:35], v[42:43] op_sel:[0,0,0] op_sel_hi:[1,0,1]
    v_lshlrev_b32 v44, 16, v28
    v_and_b32 v45, s76, v28
    v_lshlrev_b32 v46, 16, v29
    v_and_b32 v47, s76, v29
    v_pk_fma_f32 v[40:41], v[44:45], v[34:35], v[40:41] op_sel:[0,1,0] op_sel_hi:[1,1,1]
    v_pk_fma_f32 v[42:43], v[46:47], v[34:35], v[42:43] op_sel:[0,1,0] op_sel_hi:[1,1,1]
    v_pk_mul_f32 v[40:41], v[40:41], v[36:37] op_sel_hi:[1,0]
    v_pk_mul_f32 v[42:43], v[42:43], v[36:37] op_sel_hi:[1,0]
    v_cvt_pk_bf16_f32 v180, v40, v41
    v_cvt_pk_bf16_f32 v181, v42, v43
    ds_bpermute_b32 v180, v12, v180
    ds_bpermute_b32 v181, v12, v181
    s_waitcnt lgkmcnt(0)
    v_mfma_f32_16x16x16_bf16 v[112:115], v[180:181], v[80:81], 0
    v_mfma_f32_16x16x16_bf16 v[116:119], v[180:181], v[82:83], 0
    v_mfma_f32_16x16x16_bf16 v[120:123], v[180:181], v[84:85], 0
    v_mfma_f32_16x16x16_bf16 v[124:127], v[180:181], v[86:87], 0
    v_mfma_f32_16x16x16_bf16 v[128:131], v[180:181], v[88:89], 0
    v_mfma_f32_16x16x16_bf16 v[132:135], v[180:181], v[90:91], 0
    v_mfma_f32_16x16x16_bf16 v[136:139], v[180:181], v[92:93], 0
    v_mfma_f32_16x16x16_bf16 v[140:143], v[180:181], v[94:95], 0
    s_mov_b64 exec, s[62:63]
    ds_write_b128 v189, v[112:115] offset:0
    ds_write_b128 v189, v[116:119] offset:1024
    ds_write_b128 v189, v[120:123] offset:2048
    ds_write_b128 v189, v[124:127] offset:3072
    ds_write_b128 v189, v[128:131] offset:4096
    ds_write_b128 v189, v[132:135] offset:5120
    ds_write_b128 v189, v[136:139] offset:6144
    ds_write_b128 v189, v[140:143] offset:7168
    s_mov_b64 exec, -1
    s_waitcnt lgkmcnt(0)
    s_barrier
    v_add_u32 v3, 1024, v190
    ds_read2_b32 v[48:49], v190 offset0:0 offset1:32
    ds_read2_b32 v[50:51], v190 offset0:64 offset1:96
    ds_read2_b32 v[52:53], v190 offset0:128 offset1:160
    ds_read2_b32 v[54:55], v190 offset0:192 offset1:224
    ds_read2_b32 v[56:57], v3 offset0:0 offset1:32
    ds_read2_b32 v[58:59], v3 offset0:64 offset1:96
    ds_read2_b32 v[60:61], v3 offset0:128 offset1:160
    ds_read2_b32 v[62:63], v3 offset0:192 offset1:224
    s_waitcnt lgkmcnt(4)
    v_pk_add_f32 v[48:49], v[48:49], v[50:51]
    v_pk_add_f32 v[52:53], v[52:53], v[54:55]
    v_pk_add_f32 v[48:49], v[48:49], v[52:53]
    s_waitcnt lgkmcnt(0)
    v_add_f32 v8, v48, v49
    v_pk_add_f32 v[56:57], v[56:57], v[58:59]
    v_pk_add_f32 v[60:61], v[60:61], v[62:63]
    v_pk_add_f32 v[56:57], v[56:57], v[60:61]
    v_add_f32 v9, v56, v57
    buffer_store_dwordx4 v[8:11], v186, s[36:39], s78 offen sc1
    s_getreg_b32 s67, hwreg(HW_REG_XCC_ID, 0, 3)
    v_xor_b32 v3, v18, v22
    v_xor_b32 v4, v26, v30
    v_xor_b32 v5, s67, v18
    v_xor_b32 v6, s67, v26
    v_or_b32 v3, v3, v4
    v_or3_b32 v3, v3, v5, v6
    v_and_b32 v3, 7, v3
    v_cmp_ne_u32 vcc, 0, v3
    s_nop 4
    s_cbranch_vccz L_A_local
    buffer_wbl2 sc1
    s_waitcnt vmcnt(0)
L_A_local:
    s_endpgm
L_codeend:
.section .rodata,"a"
.p2align 6
.amdhsa_kernel recurrent_scan__sliding_block_cached__geglu_ffn__decode_kernel
  .amdhsa_next_free_vgpr 256
  .amdhsa_next_free_sgpr 102
  .amdhsa_accum_offset 192
  .amdhsa_group_segment_fixed_size 0
  .amdhsa_kernarg_size 96
  .amdhsa_user_sgpr_count 2
  .amdhsa_user_sgpr_kernarg_segment_ptr 1
  .amdhsa_system_sgpr_workgroup_id_x 1
  .amdhsa_float_denorm_mode_32 3
.end_amdhsa_kernel
```
